```python
import torch

def _softmax(x, axis=-1):
    return torch.softmax(x, dim=axis)
def _gelu(x):
    return torch.nn.functional.gelu(x, approximate="tanh")
def _silu(x):
    return torch.nn.functional.silu(x)
def _sigmoid(x):
    return torch.sigmoid(x)
def _layernorm(x, axis=-1, eps=1e-5):
    m = x.mean(dim=axis, keepdim=True)
    v = x.var(dim=axis, keepdim=True, unbiased=False)
    return (x - m) / torch.sqrt(v + eps)
def _scatter_add(tgt, idx, src, axis=0):
    return tgt.clone().index_add_(axis, idx, src)
def _segment_sum(src, seg, n):
    out = torch.zeros((n,) + src.shape[1:], dtype=src.dtype)
    return out.index_add_(0, seg, src)
def _pad(x, pw):
    flat = tuple(v for pair in reversed(pw) for v in pair)
    return torch.nn.functional.pad(x, flat)

kernel_name = 'standalone__linear_kernel_rfa__decode'

def setup_inputs():

    _w = (lambda a: (lambda t: t.to(torch.bfloat16) if t.is_floating_point() else t)(torch.as_tensor(a)))
    B, H, Sq, Sk, D, M = 4, 32, 1, 8192, 128, 16
    return {
        "q": _w((lambda *s: torch.randn(*s, dtype=torch.bfloat16) * 0.4)(B, H, Sq, D)),
        "k": _w((lambda *s: torch.randn(*s, dtype=torch.bfloat16) * 1.6)(B, H, Sk, D)),
        "v": _w((lambda *s: torch.randn(*s, dtype=torch.bfloat16) * 1.6)(B, H, Sk, D)),
        "omega": _w((lambda *s: torch.randn(*s, dtype=torch.bfloat16) * 1.6)(M, D)),
    }

def reference(q, k, v, omega):
    d = q.shape[-1]
    m = omega.shape[0]
    scale = float(d) ** -0.25
    qs = q * scale
    ks = k * scale
    q_proj = torch.einsum("bhsd,md->bhsm", qs, omega)
    k_proj = torch.einsum("bhsd,md->bhsm", ks, omega)
    q_sq = 0.5 * torch.einsum("bhsd,bhsd->bhs", qs, qs)[..., None]
    k_sq = 0.5 * torch.einsum("bhsd,bhsd->bhs", ks, ks)[..., None]
    inv_sqrt_m = float(m) ** -0.5
    phi_q = torch.exp(q_proj - q_sq) * inv_sqrt_m + 1e-6
    phi_k = torch.exp(k_proj - k_sq) * inv_sqrt_m + 1e-6
    kv = torch.einsum("bhsm,bhsd->bhmd", phi_k, v)
    z  = torch.einsum("bhsm->bhm", phi_k)
    num = torch.einsum("bhqm,bhmd->bhqd", phi_q, kv)
    den = torch.einsum("bhqm,bhm->bhq", phi_q, z)[..., None] + 1e-6
    return num / den
```

```asm
; @launch grid=(256,1,1) block=(256,1,1) lds=0
.amdgcn_target "amdgcn-amd-amdhsa--gfx950"
.text
.globl standalone__linear_kernel_rfa__decode_kernel
.p2align 8
.type standalone__linear_kernel_rfa__decode_kernel,@function
standalone__linear_kernel_rfa__decode_kernel:
    s_cmp_ge_u32 s2, 256
    s_cbranch_scc1 L_end
    s_load_dwordx8 s[4:11], s[0:1], 0
    s_load_dwordx4 s[12:15], s[0:1], 32
    s_load_dwordx2 s[16:17], s[0:1], 48
    v_lshrrev_b32 v1, 6, v0
    v_and_b32 v5, 63, v0
    v_readfirstlane_b32 s3, v1
    v_bfe_u32 v42, v0, 4, 2
    v_lshlrev_b32 v1, 4, v42
    v_bfe_u32 v44, v0, 2, 2
    v_lshl_add_u32 v1, v44, 8, v1
    v_bfe_u32 v44, v0, 0, 1
    v_lshl_add_u32 v1, v44, 10, v1
    v_bfe_u32 v44, v0, 1, 1
    v_lshl_add_u32 v1, v44, 15, v1
    v_lshlrev_b32 v2, 4, v5
    v_add_u32 v148, 0x8000, v2
    v_and_b32 v43, 15, v0
    v_lshlrev_b32 v144, 4, v42
    v_lshl_add_u32 v43, v43, 8, v144
    s_lshr_b32 s78, s2, 3
    s_lshl2_add_u32 s78, s78, s3
    s_bfe_u32 s19, s78, 0x10000
    s_bfe_u32 s18, s78, 0x10001
    s_lshl_b32 s18, s18, 3
    s_or_b32 s19, s19, s18
    s_bfe_u32 s18, s78, 0x10002
    s_lshl_b32 s18, s18, 2
    s_or_b32 s19, s19, s18
    s_bfe_u32 s18, s78, 0x10003
    s_lshl_b32 s18, s18, 1
    s_or_b32 s19, s19, s18
    s_bfe_u32 s18, s78, 0x10004
    s_lshl_b32 s18, s18, 4
    s_or_b32 s19, s19, s18
    s_bfe_u32 s18, s78, 0x10005
    s_lshl_b32 s18, s18, 6
    s_or_b32 s19, s19, s18
    s_bfe_u32 s18, s78, 0x10006
    s_lshl_b32 s18, s18, 5
    s_or_b32 s19, s19, s18
    s_lshr_b32 s79, s78, 2
    s_mul_i32 s79, s79, 4
    s_add_u32 s64, s79, s2
    s_bfe_u32 s33, s64, 0x10000
    s_lshl_b32 s33, s33, 18
    s_bfe_u32 s18, s64, 0x20001
    s_lshl_b32 s18, s18, 11
    s_or_b32 s33, s33, s18
    s_lshr_b32 s18, s78, 0
    s_mul_i32 s18, s18, 36
    v_xor_b32 v41, s18, v0
    v_mov_b32 v150, 0
    v_bfe_u32 v44, v41, 0, 1
    v_lshl_add_u32 v150, v44, 19, v150
    v_bfe_u32 v44, v41, 1, 1
    v_lshl_add_u32 v150, v44, 17, v150
    v_bfe_u32 v44, v41, 2, 1
    v_lshl_add_u32 v150, v44, 16, v150
    v_bfe_u32 v44, v41, 3, 1
    v_lshl_add_u32 v150, v44, 14, v150
    v_bfe_u32 v44, v41, 4, 1
    v_lshl_add_u32 v150, v44, 13, v150
    v_bfe_u32 v44, v41, 5, 1
    v_lshl_add_u32 v150, v44, 20, v150
    s_lshl_b32 s18, s19, 21
    v_readlane_b32 s32, v150, 0
    s_mov_b32 s22, 0x200000
    s_mov_b32 s23, 0x00020000
    s_mov_b32 s26, 0x200000
    s_mov_b32 s27, 0x00020000
    s_mov_b32 s30, 4096
    s_mov_b32 s31, 0x00020000
    s_or_b32 s32, s32, s33
    s_waitcnt lgkmcnt(0)
    s_mov_b32 s28, s10
    s_mov_b32 s29, s11
    s_add_u32 s20, s6, s18
    s_addc_u32 s21, s7, 0
    s_add_u32 s24, s8, s18
    s_addc_u32 s25, s9, 0
    buffer_load_dwordx4 v[48:51], v43, s[28:31], 0 offen offset:0
    buffer_load_dwordx4 v[52:55], v43, s[28:31], 0 offen offset:64
    buffer_load_dwordx4 v[56:59], v43, s[28:31], 0 offen offset:128
    buffer_load_dwordx4 v[60:63], v43, s[28:31], 0 offen offset:192
    buffer_load_dwordx4 v[96:99], v1, s[20:23], s32 offen offset:0 nt
    buffer_load_dwordx4 v[100:103], v1, s[20:23], s32 offen offset:64 nt
    buffer_load_dwordx4 v[104:107], v1, s[20:23], s32 offen offset:128 nt
    buffer_load_dwordx4 v[108:111], v1, s[20:23], s32 offen offset:192 nt
    buffer_load_dwordx4 v[112:115], v2, s[24:27], s32 offen offset:0 nt
    buffer_load_dwordx4 v[116:119], v2, s[24:27], s32 offen offset:1024 nt
    buffer_load_dwordx4 v[120:123], v148, s[24:27], s32 offen offset:0 nt
    buffer_load_dwordx4 v[124:127], v148, s[24:27], s32 offen offset:1024 nt
    s_and_b32 s66, s2, 7
    s_mov_b32 s28, s16
    s_mov_b32 s29, s17
    s_mov_b32 s30, 2129920
    s_mov_b32 s44, s4
    s_mov_b32 s45, s5
    s_mov_b32 s46, 32768
    s_mov_b32 s47, 0x00020000
    s_lshl_b32 s74, s19, 8
    s_lshl_b32 s73, s78, 12
    s_and_b32 s18, s78, 127
    s_mul_i32 s18, s18, 256
    s_add_u32 s18, s18, 2097152
    s_add_u32 s68, s16, s18
    s_addc_u32 s69, s17, 0
    s_mov_b32 s9, s18
    v_mov_b32 v151, 0
    s_lshr_b32 s18, s78, 5
    s_lshl_b32 s18, s18, 2
    s_add_u32 s70, s14, s18
    s_addc_u32 s71, s15, 0
    s_lshl_b32 s67, 1, s78
    s_mov_b32 s39, s67
    s_mov_b32 s34, 0xffff0000
    s_mov_b32 s35, 0x3fb8aa3b
    s_mov_b32 s36, 0x35860000
    s_mov_b32 s37, 0x05040100
    s_mov_b32 s38, 0x07060302
    s_mov_b32 s40, 0x3e9837f0
    s_mov_b32 s41, 0x3e9837f0
    s_mov_b32 s75, 1000000
    s_mov_b32 s4, 0
    s_mov_b32 s5, 0
    s_mov_b32 s8, 0
    v_mov_b32 v6, 0xbf00bf00
    v_mov_b32 v7, 0xbf00bf00
    v_mov_b32 v8, 0x3f803f80
    v_mov_b32 v9, 0x3f803f80
    v_and_b32 v40, 15, v0
    v_lshlrev_b32 v41, 2, v42
    v_sub_u32 v40, v40, v41
    v_mov_b32 v41, 0xffff
    v_mov_b32 v42, s34
    v_mov_b32 v3, 0
    v_mov_b32 v4, 0
    v_cmp_eq_u32 vcc, 0, v40
    s_nop 1
    v_cndmask_b32 v3, v3, v41, vcc
    v_cmp_eq_u32 vcc, 1, v40
    s_nop 1
    v_cndmask_b32 v3, v3, v42, vcc
    v_cmp_eq_u32 vcc, 2, v40
    s_nop 1
    v_cndmask_b32 v4, v4, v41, vcc
    v_cmp_eq_u32 vcc, 3, v40
    s_nop 1
    v_cndmask_b32 v4, v4, v42, vcc
    v_mov_b32 v64, 0
    v_mov_b32 v65, 0
    v_mov_b32 v66, 0
    v_mov_b32 v67, 0
    v_mov_b32 v68, 0
    v_mov_b32 v69, 0
    v_mov_b32 v70, 0
    v_mov_b32 v71, 0
    v_mov_b32 v72, 0
    v_mov_b32 v73, 0
    v_mov_b32 v74, 0
    v_mov_b32 v75, 0
    v_mov_b32 v76, 0
    v_mov_b32 v77, 0
    v_mov_b32 v78, 0
    v_mov_b32 v79, 0
    v_mov_b32 v80, 0
    v_mov_b32 v81, 0
    v_mov_b32 v82, 0
    v_mov_b32 v83, 0
    v_mov_b32 v84, 0
    v_mov_b32 v85, 0
    v_mov_b32 v86, 0
    v_mov_b32 v87, 0
    v_mov_b32 v88, 0
    v_mov_b32 v89, 0
    v_mov_b32 v90, 0
    v_mov_b32 v91, 0
    v_mov_b32 v92, 0
    v_mov_b32 v93, 0
    v_mov_b32 v94, 0
    v_mov_b32 v95, 0
    v_mov_b32 v28, 0
    v_mov_b32 v29, 0
    v_mov_b32 v30, 0
    v_mov_b32 v31, 0
    v_lshlrev_b32 v145, 3, v5
    v_mov_b32 v0, 0x3e800000
    s_mov_b32 s43, 1
    s_mov_b32 s42, 59
.p2align 3
L_loop:
    v_readlane_b32 s32, v150, s43
    s_add_u32 s43, s43, 1
    s_or_b32 s32, s32, s33
    s_waitcnt vmcnt(7)
    v_lshlrev_b32 v40, 16, v96
    v_and_b32 v41, s34, v96
    v_lshlrev_b32 v42, 16, v97
    v_and_b32 v43, s34, v97
    v_lshlrev_b32 v44, 16, v98
    v_and_b32 v45, s34, v98
    v_lshlrev_b32 v46, 16, v99
    v_and_b32 v47, s34, v99
    v_pk_mul_f32 v[40:41], v[40:41], s[40:41]
    v_pk_mul_f32 v[42:43], v[42:43], s[40:41]
    v_pk_mul_f32 v[44:45], v[44:45], s[40:41]
    v_pk_mul_f32 v[46:47], v[46:47], s[40:41]
    v_cvt_pk_bf16_f32 v32, v40, v41
    v_cvt_pk_bf16_f32 v33, v42, v43
    v_cvt_pk_bf16_f32 v34, v44, v45
    v_cvt_pk_bf16_f32 v35, v46, v47
    s_nop 1
    v_mfma_f32_16x16x32_bf16 v[20:23], v[32:35], v[32:35], 0
    v_mfma_f32_16x16x32_bf16 v[16:19], v[32:35], v[48:51], 0
    s_waitcnt vmcnt(6)
    v_lshlrev_b32 v40, 16, v100
    v_and_b32 v41, s34, v100
    v_lshlrev_b32 v42, 16, v101
    v_and_b32 v43, s34, v101
    v_lshlrev_b32 v44, 16, v102
    v_and_b32 v45, s34, v102
    v_lshlrev_b32 v46, 16, v103
    v_and_b32 v47, s34, v103
    v_pk_mul_f32 v[40:41], v[40:41], s[40:41]
    v_pk_mul_f32 v[42:43], v[42:43], s[40:41]
    v_pk_mul_f32 v[44:45], v[44:45], s[40:41]
    v_pk_mul_f32 v[46:47], v[46:47], s[40:41]
    v_cvt_pk_bf16_f32 v36, v40, v41
    v_cvt_pk_bf16_f32 v37, v42, v43
    v_cvt_pk_bf16_f32 v38, v44, v45
    v_cvt_pk_bf16_f32 v39, v46, v47
    s_nop 1
    v_mfma_f32_16x16x32_bf16 v[20:23], v[36:39], v[36:39], v[20:23]
    v_mfma_f32_16x16x32_bf16 v[16:19], v[36:39], v[52:55], v[16:19]
    s_waitcnt vmcnt(5)
    v_lshlrev_b32 v40, 16, v104
    v_and_b32 v41, s34, v104
    v_lshlrev_b32 v42, 16, v105
    v_and_b32 v43, s34, v105
    v_lshlrev_b32 v44, 16, v106
    v_and_b32 v45, s34, v106
    v_lshlrev_b32 v46, 16, v107
    v_and_b32 v47, s34, v107
    v_pk_mul_f32 v[40:41], v[40:41], s[40:41]
    v_pk_mul_f32 v[42:43], v[42:43], s[40:41]
    v_pk_mul_f32 v[44:45], v[44:45], s[40:41]
    v_pk_mul_f32 v[46:47], v[46:47], s[40:41]
    v_cvt_pk_bf16_f32 v32, v40, v41
    v_cvt_pk_bf16_f32 v33, v42, v43
    v_cvt_pk_bf16_f32 v34, v44, v45
    v_cvt_pk_bf16_f32 v35, v46, v47
    s_nop 1
    v_mfma_f32_16x16x32_bf16 v[20:23], v[32:35], v[32:35], v[20:23]
    v_mfma_f32_16x16x32_bf16 v[16:19], v[32:35], v[56:59], v[16:19]
    s_waitcnt vmcnt(4)
    v_lshlrev_b32 v40, 16, v108
    v_and_b32 v41, s34, v108
    v_lshlrev_b32 v42, 16, v109
    v_and_b32 v43, s34, v109
    v_lshlrev_b32 v44, 16, v110
    v_and_b32 v45, s34, v110
    v_lshlrev_b32 v46, 16, v111
    v_and_b32 v47, s34, v111
    v_pk_mul_f32 v[40:41], v[40:41], s[40:41]
    v_pk_mul_f32 v[42:43], v[42:43], s[40:41]
    v_pk_mul_f32 v[44:45], v[44:45], s[40:41]
    v_pk_mul_f32 v[46:47], v[46:47], s[40:41]
    v_cvt_pk_bf16_f32 v36, v40, v41
    v_cvt_pk_bf16_f32 v37, v42, v43
    v_cvt_pk_bf16_f32 v38, v44, v45
    v_cvt_pk_bf16_f32 v39, v46, v47
    s_nop 1
    v_mfma_f32_16x16x32_bf16 v[20:23], v[36:39], v[36:39], v[20:23]
    v_mfma_f32_16x16x32_bf16 v[16:19], v[36:39], v[60:63], v[16:19]
    s_nop 6
    v_cvt_pk_bf16_f32 v10, v20, v21
    v_cvt_pk_bf16_f32 v11, v22, v23
    v_and_b32 v10, v10, v3
    v_and_b32 v11, v11, v4
    v_cvt_pk_bf16_f32 v40, v16, v17
    v_cvt_pk_bf16_f32 v41, v18, v19
    v_lshlrev_b32 v16, 16, v40
    v_and_b32 v17, s34, v40
    v_lshlrev_b32 v18, 16, v41
    v_and_b32 v19, s34, v41
    s_nop 1
    v_mfma_f32_16x16x16_bf16 v[16:19], v[10:11], v[6:7], v[16:19]
    s_nop 7
    v_cvt_pk_bf16_f32 v40, v16, v17
    v_cvt_pk_bf16_f32 v41, v18, v19
    v_lshlrev_b32 v16, 16, v40
    v_and_b32 v17, s34, v40
    v_lshlrev_b32 v18, 16, v41
    v_and_b32 v19, s34, v41
    v_mul_f32 v16, s35, v16
    v_mul_f32 v17, s35, v17
    v_mul_f32 v18, s35, v18
    v_mul_f32 v19, s35, v19
    v_exp_f32 v16, v16
    v_exp_f32 v17, v17
    v_exp_f32 v18, v18
    v_exp_f32 v19, v19
    s_nop 0
    v_cvt_pk_bf16_f32 v40, v16, v17
    v_cvt_pk_bf16_f32 v41, v18, v19
    v_lshlrev_b32 v16, 16, v40
    v_and_b32 v17, s34, v40
    v_lshlrev_b32 v18, 16, v41
    v_and_b32 v19, s34, v41
    v_fmaak_f32 v16, v16, v0, 0x35860000
    v_fmaak_f32 v17, v17, v0, 0x35860000
    v_fmaak_f32 v18, v18, v0, 0x35860000
    v_fmaak_f32 v19, v19, v0, 0x35860000
    v_cvt_pk_bf16_f32 v10, v16, v17
    v_cvt_pk_bf16_f32 v11, v18, v19
    s_waitcnt vmcnt(0)
    v_perm_b32 v12, v116, v112, s37
    v_perm_b32 v13, v124, v120, s37
    v_mfma_f32_16x16x16_bf16 v[28:31], v[10:11], v[8:9], v[28:31]
    v_perm_b32 v14, v116, v112, s38
    v_perm_b32 v15, v124, v120, s38
    v_mfma_f32_16x16x16_bf16 v[64:67], v[10:11], v[12:13], v[64:67]
    v_perm_b32 v12, v117, v113, s37
    v_perm_b32 v13, v125, v121, s37
    v_mfma_f32_16x16x16_bf16 v[68:71], v[10:11], v[14:15], v[68:71]
    v_perm_b32 v14, v117, v113, s38
    v_perm_b32 v15, v125, v121, s38
    v_mfma_f32_16x16x16_bf16 v[72:75], v[10:11], v[12:13], v[72:75]
    v_perm_b32 v12, v118, v114, s37
    v_perm_b32 v13, v126, v122, s37
    v_mfma_f32_16x16x16_bf16 v[76:79], v[10:11], v[14:15], v[76:79]
    v_perm_b32 v14, v118, v114, s38
    v_perm_b32 v15, v126, v122, s38
    v_mfma_f32_16x16x16_bf16 v[80:83], v[10:11], v[12:13], v[80:83]
    v_perm_b32 v12, v119, v115, s37
    v_perm_b32 v13, v127, v123, s37
    v_mfma_f32_16x16x16_bf16 v[84:87], v[10:11], v[14:15], v[84:87]
    v_perm_b32 v14, v119, v115, s38
    v_perm_b32 v15, v127, v123, s38
    v_mfma_f32_16x16x16_bf16 v[88:91], v[10:11], v[12:13], v[88:91]
    buffer_load_dwordx4 v[96:99], v1, s[20:23], s32 offen offset:0 nt
    buffer_load_dwordx4 v[100:103], v1, s[20:23], s32 offen offset:64 nt
    buffer_load_dwordx4 v[104:107], v1, s[20:23], s32 offen offset:128 nt
    buffer_load_dwordx4 v[108:111], v1, s[20:23], s32 offen offset:192 nt
    buffer_load_dwordx4 v[112:115], v2, s[24:27], s32 offen offset:0 nt
    buffer_load_dwordx4 v[116:119], v2, s[24:27], s32 offen offset:1024 nt
    buffer_load_dwordx4 v[120:123], v148, s[24:27], s32 offen offset:0 nt
    buffer_load_dwordx4 v[124:127], v148, s[24:27], s32 offen offset:1024 nt
    v_mfma_f32_16x16x16_bf16 v[92:95], v[10:11], v[14:15], v[92:95]
    s_sub_u32 s42, s42, 1
    s_cbranch_scc1 L_next
    s_sub_u32 s18, s42, 56
    s_cmp_lt_u32 s18, 2
    s_cbranch_scc1 L_job0
    s_sub_u32 s18, s42, 8
    s_cmp_gt_u32 s18, 1
    s_cbranch_scc1 L_loop
    s_cmp_eq_u32 s18, 0
    s_cbranch_scc1 L_job2
    buffer_load_dwordx4 v[128:131], v144, s[44:47], s74 offen offset:0
    buffer_load_dwordx4 v[132:135], v144, s[44:47], s74 offen offset:64
    buffer_load_dwordx4 v[136:139], v144, s[44:47], s74 offen offset:128
    buffer_load_dwordx4 v[140:143], v144, s[44:47], s74 offen offset:192
    s_branch L_loop
L_job0:
    s_cmp_eq_u32 s18, 0
    s_cbranch_scc1 L_job0b
    s_cmp_eq_u32 s66, 0
    s_cbranch_scc1 L_job0p
    s_lshl_b32 s18, s66, 9
    s_add_u32 s73, s73, s18
    buffer_load_dwordx2 v[152:153], v145, s[28:31], s73 offen sc1
    s_branch L_loop
L_job0p:
    buffer_load_dwordx2 v[152:153], v145, s[28:31], s73 offen offset:512 sc1
    buffer_load_dwordx2 v[154:155], v145, s[28:31], s73 offen offset:1024 sc1
    buffer_load_dwordx2 v[156:157], v145, s[28:31], s73 offen offset:1536 sc1
    buffer_load_dwordx2 v[158:159], v145, s[28:31], s73 offen offset:2048 sc1
    buffer_load_dwordx2 v[160:161], v145, s[28:31], s73 offen offset:2560 sc1
    buffer_load_dwordx2 v[162:163], v145, s[28:31], s73 offen offset:3072 sc1
    buffer_load_dwordx2 v[164:165], v145, s[28:31], s73 offen offset:3584 sc1
    s_mov_b64 exec, 1
    buffer_store_dword v151, v151, s[28:31], s9 offen sc1
    s_mov_b64 exec, -1
    s_branch L_loop
L_job0b:
    s_cmp_eq_u32 s66, 0
    s_cbranch_scc1 L_job0q
    v_not_b32 v152, v152
    v_not_b32 v153, v153
    v_and_b32 v152, 1, v152
    s_branch L_loop
L_job0q:
L_job0r:
    s_atomic_or s67, s[70:71], 0
    s_branch L_loop
L_job2:
    s_load_dword s65, s[70:71], 0
    v_lshlrev_b32 v40, 16, v128
    v_and_b32 v41, s34, v128
    v_lshlrev_b32 v42, 16, v129
    v_and_b32 v43, s34, v129
    v_lshlrev_b32 v44, 16, v130
    v_and_b32 v45, s34, v130
    v_lshlrev_b32 v46, 16, v131
    v_and_b32 v47, s34, v131
    v_pk_mul_f32 v[40:41], v[40:41], s[40:41]
    v_pk_mul_f32 v[42:43], v[42:43], s[40:41]
    v_pk_mul_f32 v[44:45], v[44:45], s[40:41]
    v_pk_mul_f32 v[46:47], v[46:47], s[40:41]
    v_cvt_pk_bf16_f32 v32, v40, v41
    v_cvt_pk_bf16_f32 v33, v42, v43
    v_cvt_pk_bf16_f32 v34, v44, v45
    v_cvt_pk_bf16_f32 v35, v46, v47
    s_nop 1
    v_mfma_f32_16x16x32_bf16 v[24:27], v[48:51], v[32:35], 0
    v_mfma_f32_16x16x32_bf16 v[20:23], v[32:35], v[32:35], 0
    v_lshlrev_b32 v40, 16, v132
    v_and_b32 v41, s34, v132
    v_lshlrev_b32 v42, 16, v133
    v_and_b32 v43, s34, v133
    v_lshlrev_b32 v44, 16, v134
    v_and_b32 v45, s34, v134
    v_lshlrev_b32 v46, 16, v135
    v_and_b32 v47, s34, v135
    v_pk_mul_f32 v[40:41], v[40:41], s[40:41]
    v_pk_mul_f32 v[42:43], v[42:43], s[40:41]
    v_pk_mul_f32 v[44:45], v[44:45], s[40:41]
    v_pk_mul_f32 v[46:47], v[46:47], s[40:41]
    v_cvt_pk_bf16_f32 v36, v40, v41
    v_cvt_pk_bf16_f32 v37, v42, v43
    v_cvt_pk_bf16_f32 v38, v44, v45
    v_cvt_pk_bf16_f32 v39, v46, v47
    s_nop 1
    v_mfma_f32_16x16x32_bf16 v[24:27], v[52:55], v[36:39], v[24:27]
    v_mfma_f32_16x16x32_bf16 v[20:23], v[36:39], v[36:39], v[20:23]
    v_lshlrev_b32 v40, 16, v136
    v_and_b32 v41, s34, v136
    v_lshlrev_b32 v42, 16, v137
    v_and_b32 v43, s34, v137
    v_lshlrev_b32 v44, 16, v138
    v_and_b32 v45, s34, v138
    v_lshlrev_b32 v46, 16, v139
    v_and_b32 v47, s34, v139
    v_pk_mul_f32 v[40:41], v[40:41], s[40:41]
    v_pk_mul_f32 v[42:43], v[42:43], s[40:41]
    v_pk_mul_f32 v[44:45], v[44:45], s[40:41]
    v_pk_mul_f32 v[46:47], v[46:47], s[40:41]
    v_cvt_pk_bf16_f32 v32, v40, v41
    v_cvt_pk_bf16_f32 v33, v42, v43
    v_cvt_pk_bf16_f32 v34, v44, v45
    v_cvt_pk_bf16_f32 v35, v46, v47
    s_nop 1
    v_mfma_f32_16x16x32_bf16 v[24:27], v[56:59], v[32:35], v[24:27]
    v_mfma_f32_16x16x32_bf16 v[20:23], v[32:35], v[32:35], v[20:23]
    v_lshlrev_b32 v40, 16, v140
    v_and_b32 v41, s34, v140
    v_lshlrev_b32 v42, 16, v141
    v_and_b32 v43, s34, v141
    v_lshlrev_b32 v44, 16, v142
    v_and_b32 v45, s34, v142
    v_lshlrev_b32 v46, 16, v143
    v_and_b32 v47, s34, v143
    v_pk_mul_f32 v[40:41], v[40:41], s[40:41]
    v_pk_mul_f32 v[42:43], v[42:43], s[40:41]
    v_pk_mul_f32 v[44:45], v[44:45], s[40:41]
    v_pk_mul_f32 v[46:47], v[46:47], s[40:41]
    v_cvt_pk_bf16_f32 v36, v40, v41
    v_cvt_pk_bf16_f32 v37, v42, v43
    v_cvt_pk_bf16_f32 v38, v44, v45
    v_cvt_pk_bf16_f32 v39, v46, v47
    s_nop 1
    v_mfma_f32_16x16x32_bf16 v[24:27], v[60:63], v[36:39], v[24:27]
    v_mfma_f32_16x16x32_bf16 v[20:23], v[36:39], v[36:39], v[20:23]
    s_nop 7
    v_cvt_pk_bf16_f32 v40, v24, v25
    v_cvt_pk_bf16_f32 v41, v26, v27
    v_lshlrev_b32 v24, 16, v40
    v_and_b32 v25, s34, v40
    v_lshlrev_b32 v26, 16, v41
    v_and_b32 v27, s34, v41
    v_cvt_pk_bf16_f32 v40, v20, v21
    v_cvt_pk_bf16_f32 v41, v22, v23
    v_lshlrev_b32 v20, 16, v40
    v_and_b32 v21, s34, v40
    v_lshlrev_b32 v22, 16, v41
    v_and_b32 v23, s34, v41
    v_fma_f32 v24, v20, -0.5, v24
    v_fma_f32 v25, v21, -0.5, v25
    v_fma_f32 v26, v22, -0.5, v26
    v_fma_f32 v27, v23, -0.5, v27
    v_cvt_pk_bf16_f32 v40, v24, v25
    v_cvt_pk_bf16_f32 v41, v26, v27
    v_lshlrev_b32 v24, 16, v40
    v_and_b32 v25, s34, v40
    v_lshlrev_b32 v26, 16, v41
    v_and_b32 v27, s34, v41
    v_mul_f32 v24, s35, v24
    v_mul_f32 v25, s35, v25
    v_mul_f32 v26, s35, v26
    v_mul_f32 v27, s35, v27
    v_exp_f32 v24, v24
    v_exp_f32 v25, v25
    v_exp_f32 v26, v26
    v_exp_f32 v27, v27
    s_nop 0
    v_cvt_pk_bf16_f32 v40, v24, v25
    v_cvt_pk_bf16_f32 v41, v26, v27
    v_lshlrev_b32 v24, 16, v40
    v_and_b32 v25, s34, v40
    v_lshlrev_b32 v26, 16, v41
    v_and_b32 v27, s34, v41
    v_fmaak_f32 v24, v24, v0, 0x35860000
    v_fmaak_f32 v25, v25, v0, 0x35860000
    v_fmaak_f32 v26, v26, v0, 0x35860000
    v_fmaak_f32 v27, v27, v0, 0x35860000
    v_cvt_pk_bf16_f32 v40, v24, v25
    v_cvt_pk_bf16_f32 v41, v26, v27
    v_lshlrev_b32 v24, 16, v40
    v_and_b32 v25, s34, v40
    v_lshlrev_b32 v26, 16, v41
    v_and_b32 v27, s34, v41
    s_mov_b32 s44, s12
    s_mov_b32 s45, s13
    v_and_b32 v144, 15, v5
    v_lshrrev_b32 v40, 4, v5
    v_lshlrev_b32 v144, 4, v144
    v_lshl_add_u32 v144, v40, 2, v144
    s_waitcnt lgkmcnt(0)
L_chk:
    s_and_b32 s65, s65, s39
    s_cmp_eq_u32 s65, s39
    s_cbranch_scc1 L_loop
    s_sleep 8
    s_mov_b32 s65, 0
    s_atomic_add s65, s[70:71], 0 glc
    s_waitcnt lgkmcnt(0)
    s_sub_u32 s75, s75, 1
    s_cbranch_scc0 L_chk
    s_branch L_end
L_next:
L_next2:
    s_sub_u32 s5, s5, 1
    s_cbranch_scc0 L_run
    s_mov_b32 s64, 1
    s_atomic_add s64, s[68:69], 0 glc
    s_mov_b32 s6, 0xa070400
    s_mov_b32 s7, 0x100f0e0c
    s_waitcnt lgkmcnt(0)
    s_cmp_ge_u32 s64, 16
    s_cbranch_scc1 L_last
    s_add_u32 s4, s64, 8
    s_mov_b32 s5, 0
    s_cmp_ge_u32 s64, 8
    s_cbranch_scc1 L_run
    s_lshl_b32 s18, s64, 3
    s_lshr_b64 s[6:7], s[6:7], s18
    s_and_b32 s4, s6, 0xff
    s_lshl_b32 s18, s64, 2
    s_lshr_b32 s5, 0x1122334, s18
    s_and_b32 s5, s5, 15
    s_branch L_next2
L_run:
    s_add_u32 s65, s4, s79
    s_bfe_u32 s33, s65, 0x10000
    s_lshl_b32 s33, s33, 18
    s_bfe_u32 s18, s65, 0x20001
    s_lshl_b32 s18, s18, 11
    s_or_b32 s33, s33, s18
    s_lshr_b32 s43, s4, 3
    s_add_u32 s43, s43, 61
    s_mov_b32 s42, 0
    s_add_u32 s4, s4, 1
    s_branch L_loop
L_last:
    s_waitcnt vmcnt(7)
    v_lshlrev_b32 v40, 16, v96
    v_and_b32 v41, s34, v96
    v_lshlrev_b32 v42, 16, v97
    v_and_b32 v43, s34, v97
    v_lshlrev_b32 v44, 16, v98
    v_and_b32 v45, s34, v98
    v_lshlrev_b32 v46, 16, v99
    v_and_b32 v47, s34, v99
    v_pk_mul_f32 v[40:41], v[40:41], s[40:41]
    v_pk_mul_f32 v[42:43], v[42:43], s[40:41]
    v_pk_mul_f32 v[44:45], v[44:45], s[40:41]
    v_pk_mul_f32 v[46:47], v[46:47], s[40:41]
    v_cvt_pk_bf16_f32 v32, v40, v41
    v_cvt_pk_bf16_f32 v33, v42, v43
    v_cvt_pk_bf16_f32 v34, v44, v45
    v_cvt_pk_bf16_f32 v35, v46, v47
    s_nop 1
    v_mfma_f32_16x16x32_bf16 v[20:23], v[32:35], v[32:35], 0
    v_mfma_f32_16x16x32_bf16 v[16:19], v[32:35], v[48:51], 0
    s_waitcnt vmcnt(6)
    v_lshlrev_b32 v40, 16, v100
    v_and_b32 v41, s34, v100
    v_lshlrev_b32 v42, 16, v101
    v_and_b32 v43, s34, v101
    v_lshlrev_b32 v44, 16, v102
    v_and_b32 v45, s34, v102
    v_lshlrev_b32 v46, 16, v103
    v_and_b32 v47, s34, v103
    v_pk_mul_f32 v[40:41], v[40:41], s[40:41]
    v_pk_mul_f32 v[42:43], v[42:43], s[40:41]
    v_pk_mul_f32 v[44:45], v[44:45], s[40:41]
    v_pk_mul_f32 v[46:47], v[46:47], s[40:41]
    v_cvt_pk_bf16_f32 v36, v40, v41
    v_cvt_pk_bf16_f32 v37, v42, v43
    v_cvt_pk_bf16_f32 v38, v44, v45
    v_cvt_pk_bf16_f32 v39, v46, v47
    s_nop 1
    v_mfma_f32_16x16x32_bf16 v[20:23], v[36:39], v[36:39], v[20:23]
    v_mfma_f32_16x16x32_bf16 v[16:19], v[36:39], v[52:55], v[16:19]
    s_waitcnt vmcnt(5)
    v_lshlrev_b32 v40, 16, v104
    v_and_b32 v41, s34, v104
    v_lshlrev_b32 v42, 16, v105
    v_and_b32 v43, s34, v105
    v_lshlrev_b32 v44, 16, v106
    v_and_b32 v45, s34, v106
    v_lshlrev_b32 v46, 16, v107
    v_and_b32 v47, s34, v107
    v_pk_mul_f32 v[40:41], v[40:41], s[40:41]
    v_pk_mul_f32 v[42:43], v[42:43], s[40:41]
    v_pk_mul_f32 v[44:45], v[44:45], s[40:41]
    v_pk_mul_f32 v[46:47], v[46:47], s[40:41]
    v_cvt_pk_bf16_f32 v32, v40, v41
    v_cvt_pk_bf16_f32 v33, v42, v43
    v_cvt_pk_bf16_f32 v34, v44, v45
    v_cvt_pk_bf16_f32 v35, v46, v47
    s_nop 1
    v_mfma_f32_16x16x32_bf16 v[20:23], v[32:35], v[32:35], v[20:23]
    v_mfma_f32_16x16x32_bf16 v[16:19], v[32:35], v[56:59], v[16:19]
    s_waitcnt vmcnt(4)
    v_lshlrev_b32 v40, 16, v108
    v_and_b32 v41, s34, v108
    v_lshlrev_b32 v42, 16, v109
    v_and_b32 v43, s34, v109
    v_lshlrev_b32 v44, 16, v110
    v_and_b32 v45, s34, v110
    v_lshlrev_b32 v46, 16, v111
    v_and_b32 v47, s34, v111
    v_pk_mul_f32 v[40:41], v[40:41], s[40:41]
    v_pk_mul_f32 v[42:43], v[42:43], s[40:41]
    v_pk_mul_f32 v[44:45], v[44:45], s[40:41]
    v_pk_mul_f32 v[46:47], v[46:47], s[40:41]
    v_cvt_pk_bf16_f32 v36, v40, v41
    v_cvt_pk_bf16_f32 v37, v42, v43
    v_cvt_pk_bf16_f32 v38, v44, v45
    v_cvt_pk_bf16_f32 v39, v46, v47
    s_nop 1
    v_mfma_f32_16x16x32_bf16 v[20:23], v[36:39], v[36:39], v[20:23]
    v_mfma_f32_16x16x32_bf16 v[16:19], v[36:39], v[60:63], v[16:19]
    s_nop 6
    v_cvt_pk_bf16_f32 v10, v20, v21
    v_cvt_pk_bf16_f32 v11, v22, v23
    v_and_b32 v10, v10, v3
    v_and_b32 v11, v11, v4
    v_cvt_pk_bf16_f32 v40, v16, v17
    v_cvt_pk_bf16_f32 v41, v18, v19
    v_lshlrev_b32 v16, 16, v40
    v_and_b32 v17, s34, v40
    v_lshlrev_b32 v18, 16, v41
    v_and_b32 v19, s34, v41
    s_nop 1
    v_mfma_f32_16x16x16_bf16 v[16:19], v[10:11], v[6:7], v[16:19]
    s_nop 7
    v_cvt_pk_bf16_f32 v40, v16, v17
    v_cvt_pk_bf16_f32 v41, v18, v19
    v_lshlrev_b32 v16, 16, v40
    v_and_b32 v17, s34, v40
    v_lshlrev_b32 v18, 16, v41
    v_and_b32 v19, s34, v41
    v_mul_f32 v16, s35, v16
    v_mul_f32 v17, s35, v17
    v_mul_f32 v18, s35, v18
    v_mul_f32 v19, s35, v19
    v_exp_f32 v16, v16
    v_exp_f32 v17, v17
    v_exp_f32 v18, v18
    v_exp_f32 v19, v19
    s_nop 0
    v_cvt_pk_bf16_f32 v40, v16, v17
    v_cvt_pk_bf16_f32 v41, v18, v19
    v_lshlrev_b32 v16, 16, v40
    v_and_b32 v17, s34, v40
    v_lshlrev_b32 v18, 16, v41
    v_and_b32 v19, s34, v41
    v_fmaak_f32 v16, v16, v0, 0x35860000
    v_fmaak_f32 v17, v17, v0, 0x35860000
    v_fmaak_f32 v18, v18, v0, 0x35860000
    v_fmaak_f32 v19, v19, v0, 0x35860000
    v_cvt_pk_bf16_f32 v10, v16, v17
    v_cvt_pk_bf16_f32 v11, v18, v19
    s_waitcnt vmcnt(0)
    v_perm_b32 v12, v116, v112, s37
    v_perm_b32 v13, v124, v120, s37
    v_mfma_f32_16x16x16_bf16 v[28:31], v[10:11], v[8:9], v[28:31]
    v_perm_b32 v14, v116, v112, s38
    v_perm_b32 v15, v124, v120, s38
    v_mfma_f32_16x16x16_bf16 v[64:67], v[10:11], v[12:13], v[64:67]
    v_perm_b32 v12, v117, v113, s37
    v_perm_b32 v13, v125, v121, s37
    v_mfma_f32_16x16x16_bf16 v[68:71], v[10:11], v[14:15], v[68:71]
    v_perm_b32 v14, v117, v113, s38
    v_perm_b32 v15, v125, v121, s38
    v_mfma_f32_16x16x16_bf16 v[72:75], v[10:11], v[12:13], v[72:75]
    v_perm_b32 v12, v118, v114, s37
    v_perm_b32 v13, v126, v122, s37
    v_mfma_f32_16x16x16_bf16 v[76:79], v[10:11], v[14:15], v[76:79]
    v_perm_b32 v14, v118, v114, s38
    v_perm_b32 v15, v126, v122, s38
    v_mfma_f32_16x16x16_bf16 v[80:83], v[10:11], v[12:13], v[80:83]
    v_perm_b32 v12, v119, v115, s37
    v_perm_b32 v13, v127, v123, s37
    v_mfma_f32_16x16x16_bf16 v[84:87], v[10:11], v[14:15], v[84:87]
    v_perm_b32 v14, v119, v115, s38
    v_perm_b32 v15, v127, v123, s38
    v_mfma_f32_16x16x16_bf16 v[88:91], v[10:11], v[12:13], v[88:91]
    s_nop 0
    v_mfma_f32_16x16x16_bf16 v[92:95], v[10:11], v[14:15], v[92:95]
    s_nop 6
    v_mul_f32 v40, v24, v28
    v_mul_f32 v32, v24, v64
    v_mul_f32 v33, v24, v68
    v_mul_f32 v34, v24, v72
    v_mul_f32 v35, v24, v76
    v_mul_f32 v36, v24, v80
    v_mul_f32 v37, v24, v84
    v_mul_f32 v38, v24, v88
    v_mul_f32 v39, v24, v92
    v_fmac_f32 v40, v25, v29
    v_fmac_f32 v32, v25, v65
    v_fmac_f32 v33, v25, v69
    v_fmac_f32 v34, v25, v73
    v_fmac_f32 v35, v25, v77
    v_fmac_f32 v36, v25, v81
    v_fmac_f32 v37, v25, v85
    v_fmac_f32 v38, v25, v89
    v_fmac_f32 v39, v25, v93
    v_fmac_f32 v40, v26, v30
    v_fmac_f32 v32, v26, v66
    v_fmac_f32 v33, v26, v70
    v_fmac_f32 v34, v26, v74
    v_fmac_f32 v35, v26, v78
    v_fmac_f32 v36, v26, v82
    v_fmac_f32 v37, v26, v86
    v_fmac_f32 v38, v26, v90
    v_fmac_f32 v39, v26, v94
    v_fmac_f32 v40, v27, v31
    v_fmac_f32 v32, v27, v67
    v_fmac_f32 v33, v27, v71
    v_fmac_f32 v34, v27, v75
    v_fmac_f32 v35, v27, v79
    v_fmac_f32 v36, v27, v83
    v_fmac_f32 v37, v27, v87
    v_fmac_f32 v38, v27, v91
    v_fmac_f32 v39, v27, v95
    v_mov_b32 v41, v40
    s_nop 0
    v_permlane32_swap_b32 v32, v36
    v_permlane32_swap_b32 v33, v37
    v_permlane32_swap_b32 v34, v38
    v_permlane32_swap_b32 v35, v39
    v_permlane32_swap_b32 v40, v41
    s_nop 1
    v_add_f32 v40, v40, v41
    v_add_f32 v32, v32, v36
    v_add_f32 v33, v33, v37
    v_add_f32 v34, v34, v38
    v_add_f32 v35, v35, v39
    v_mov_b32 v41, v40
    s_nop 0
    v_permlane16_swap_b32 v32, v34
    v_permlane16_swap_b32 v33, v35
    v_permlane16_swap_b32 v40, v41
    s_nop 1
    v_add_f32 v32, v32, v34
    v_add_f32 v33, v33, v35
    v_add_f32 v34, v40, v41
    s_cmp_eq_u32 s66, 0
    s_cbranch_scc1 L_poll0
    v_lshrrev_b32 v40, v5, v34
    v_lshl_or_b32 v40, v40, 1, v152
    v_bfi_b32 v32, 3, v40, v32
    v_bfi_b32 v33, 1, v153, v33
    buffer_store_dwordx2 v[32:33], v145, s[28:31], s73 offen sc1
    s_branch L_fin
L_poll0:
    buffer_load_dwordx2 v[66:67], v145, s[28:31], s73 offen offset:512 sc1
    buffer_load_dwordx2 v[68:69], v145, s[28:31], s73 offen offset:1024 sc1
    buffer_load_dwordx2 v[70:71], v145, s[28:31], s73 offen offset:1536 sc1
    buffer_load_dwordx2 v[72:73], v145, s[28:31], s73 offen offset:2048 sc1
    buffer_load_dwordx2 v[74:75], v145, s[28:31], s73 offen offset:2560 sc1
    buffer_load_dwordx2 v[76:77], v145, s[28:31], s73 offen offset:3072 sc1
    buffer_load_dwordx2 v[78:79], v145, s[28:31], s73 offen offset:3584 sc1
L_poll:
    buffer_load_dwordx2 v[82:83], v145, s[28:31], s73 offen offset:512 sc1
    buffer_load_dwordx2 v[84:85], v145, s[28:31], s73 offen offset:1024 sc1
    buffer_load_dwordx2 v[86:87], v145, s[28:31], s73 offen offset:1536 sc1
    buffer_load_dwordx2 v[88:89], v145, s[28:31], s73 offen offset:2048 sc1
    buffer_load_dwordx2 v[90:91], v145, s[28:31], s73 offen offset:2560 sc1
    buffer_load_dwordx2 v[92:93], v145, s[28:31], s73 offen offset:3072 sc1
    buffer_load_dwordx2 v[94:95], v145, s[28:31], s73 offen offset:3584 sc1
    v_mov_b32 v36, v32
    v_mov_b32 v37, v33
    v_mov_b32 v38, v34
    v_mov_b32 v41, 1
    s_waitcnt vmcnt(13)
    v_and_b32 v40, 2, v66
    v_cmp_ne_u32 vcc, 0, v40
    v_xor_b32 v42, v66, v152
    v_xor_b32 v43, v67, v153
    v_add_f32 v38, vcc_lo, v38
    v_and_b32 v41, v41, v42
    v_and_b32 v41, v41, v43
    v_and_b32 v42, -4, v66
    v_and_b32 v43, -2, v67
    v_add_f32 v36, v36, v42
    v_add_f32 v37, v37, v43
    s_waitcnt vmcnt(12)
    v_and_b32 v40, 2, v68
    v_cmp_ne_u32 vcc, 0, v40
    v_xor_b32 v42, v68, v154
    v_xor_b32 v43, v69, v155
    v_add_f32 v38, vcc_lo, v38
    v_and_b32 v41, v41, v42
    v_and_b32 v41, v41, v43
    v_and_b32 v42, -4, v68
    v_and_b32 v43, -2, v69
    v_add_f32 v36, v36, v42
    v_add_f32 v37, v37, v43
    s_waitcnt vmcnt(11)
    v_and_b32 v40, 2, v70
    v_cmp_ne_u32 vcc, 0, v40
    v_xor_b32 v42, v70, v156
    v_xor_b32 v43, v71, v157
    v_add_f32 v38, vcc_lo, v38
    v_and_b32 v41, v41, v42
    v_and_b32 v41, v41, v43
    v_and_b32 v42, -4, v70
    v_and_b32 v43, -2, v71
    v_add_f32 v36, v36, v42
    v_add_f32 v37, v37, v43
    s_waitcnt vmcnt(10)
    v_and_b32 v40, 2, v72
    v_cmp_ne_u32 vcc, 0, v40
    v_xor_b32 v42, v72, v158
    v_xor_b32 v43, v73, v159
    v_add_f32 v38, vcc_lo, v38
    v_and_b32 v41, v41, v42
    v_and_b32 v41, v41, v43
    v_and_b32 v42, -4, v72
    v_and_b32 v43, -2, v73
    v_add_f32 v36, v36, v42
    v_add_f32 v37, v37, v43
    s_waitcnt vmcnt(9)
    v_and_b32 v40, 2, v74
    v_cmp_ne_u32 vcc, 0, v40
    v_xor_b32 v42, v74, v160
    v_xor_b32 v43, v75, v161
    v_add_f32 v38, vcc_lo, v38
    v_and_b32 v41, v41, v42
    v_and_b32 v41, v41, v43
    v_and_b32 v42, -4, v74
    v_and_b32 v43, -2, v75
    v_add_f32 v36, v36, v42
    v_add_f32 v37, v37, v43
    s_waitcnt vmcnt(8)
    v_and_b32 v40, 2, v76
    v_cmp_ne_u32 vcc, 0, v40
    v_xor_b32 v42, v76, v162
    v_xor_b32 v43, v77, v163
    v_add_f32 v38, vcc_lo, v38
    v_and_b32 v41, v41, v42
    v_and_b32 v41, v41, v43
    v_and_b32 v42, -4, v76
    v_and_b32 v43, -2, v77
    v_add_f32 v36, v36, v42
    v_add_f32 v37, v37, v43
    s_waitcnt vmcnt(7)
    v_and_b32 v40, 2, v78
    v_cmp_ne_u32 vcc, 0, v40
    v_xor_b32 v42, v78, v164
    v_xor_b32 v43, v79, v165
    v_add_f32 v38, vcc_lo, v38
    v_and_b32 v41, v41, v42
    v_and_b32 v41, v41, v43
    v_and_b32 v42, -4, v78
    v_and_b32 v43, -2, v79
    v_add_f32 v36, v36, v42
    v_add_f32 v37, v37, v43
    v_cmp_eq_u32 vcc, 0, v41
    s_nop 4
    s_cbranch_vccz L_sum
    buffer_load_dwordx2 v[66:67], v145, s[28:31], s73 offen offset:512 sc1
    buffer_load_dwordx2 v[68:69], v145, s[28:31], s73 offen offset:1024 sc1
    buffer_load_dwordx2 v[70:71], v145, s[28:31], s73 offen offset:1536 sc1
    buffer_load_dwordx2 v[72:73], v145, s[28:31], s73 offen offset:2048 sc1
    buffer_load_dwordx2 v[74:75], v145, s[28:31], s73 offen offset:2560 sc1
    buffer_load_dwordx2 v[76:77], v145, s[28:31], s73 offen offset:3072 sc1
    buffer_load_dwordx2 v[78:79], v145, s[28:31], s73 offen offset:3584 sc1
    v_mov_b32 v36, v32
    v_mov_b32 v37, v33
    v_mov_b32 v38, v34
    v_mov_b32 v41, 1
    s_waitcnt vmcnt(13)
    v_and_b32 v40, 2, v82
    v_cmp_ne_u32 vcc, 0, v40
    v_xor_b32 v42, v82, v152
    v_xor_b32 v43, v83, v153
    v_add_f32 v38, vcc_lo, v38
    v_and_b32 v41, v41, v42
    v_and_b32 v41, v41, v43
    v_and_b32 v42, -4, v82
    v_and_b32 v43, -2, v83
    v_add_f32 v36, v36, v42
    v_add_f32 v37, v37, v43
    s_waitcnt vmcnt(12)
    v_and_b32 v40, 2, v84
    v_cmp_ne_u32 vcc, 0, v40
    v_xor_b32 v42, v84, v154
    v_xor_b32 v43, v85, v155
    v_add_f32 v38, vcc_lo, v38
    v_and_b32 v41, v41, v42
    v_and_b32 v41, v41, v43
    v_and_b32 v42, -4, v84
    v_and_b32 v43, -2, v85
    v_add_f32 v36, v36, v42
    v_add_f32 v37, v37, v43
    s_waitcnt vmcnt(11)
    v_and_b32 v40, 2, v86
    v_cmp_ne_u32 vcc, 0, v40
    v_xor_b32 v42, v86, v156
    v_xor_b32 v43, v87, v157
    v_add_f32 v38, vcc_lo, v38
    v_and_b32 v41, v41, v42
    v_and_b32 v41, v41, v43
    v_and_b32 v42, -4, v86
    v_and_b32 v43, -2, v87
    v_add_f32 v36, v36, v42
    v_add_f32 v37, v37, v43
    s_waitcnt vmcnt(10)
    v_and_b32 v40, 2, v88
    v_cmp_ne_u32 vcc, 0, v40
    v_xor_b32 v42, v88, v158
    v_xor_b32 v43, v89, v159
    v_add_f32 v38, vcc_lo, v38
    v_and_b32 v41, v41, v42
    v_and_b32 v41, v41, v43
    v_and_b32 v42, -4, v88
    v_and_b32 v43, -2, v89
    v_add_f32 v36, v36, v42
    v_add_f32 v37, v37, v43
    s_waitcnt vmcnt(9)
    v_and_b32 v40, 2, v90
    v_cmp_ne_u32 vcc, 0, v40
    v_xor_b32 v42, v90, v160
    v_xor_b32 v43, v91, v161
    v_add_f32 v38, vcc_lo, v38
    v_and_b32 v41, v41, v42
    v_and_b32 v41, v41, v43
    v_and_b32 v42, -4, v90
    v_and_b32 v43, -2, v91
    v_add_f32 v36, v36, v42
    v_add_f32 v37, v37, v43
    s_waitcnt vmcnt(8)
    v_and_b32 v40, 2, v92
    v_cmp_ne_u32 vcc, 0, v40
    v_xor_b32 v42, v92, v162
    v_xor_b32 v43, v93, v163
    v_add_f32 v38, vcc_lo, v38
    v_and_b32 v41, v41, v42
    v_and_b32 v41, v41, v43
    v_and_b32 v42, -4, v92
    v_and_b32 v43, -2, v93
    v_add_f32 v36, v36, v42
    v_add_f32 v37, v37, v43
    s_waitcnt vmcnt(7)
    v_and_b32 v40, 2, v94
    v_cmp_ne_u32 vcc, 0, v40
    v_xor_b32 v42, v94, v164
    v_xor_b32 v43, v95, v165
    v_add_f32 v38, vcc_lo, v38
    v_and_b32 v41, v41, v42
    v_and_b32 v41, v41, v43
    v_and_b32 v42, -4, v94
    v_and_b32 v43, -2, v95
    v_add_f32 v36, v36, v42
    v_add_f32 v37, v37, v43
    v_cmp_eq_u32 vcc, 0, v41
    s_nop 4
    s_cbranch_vccz L_sum
    s_sub_u32 s75, s75, 1
    s_cbranch_scc0 L_poll
    s_branch L_end
L_sum:
    v_cvt_pk_bf16_f32 v40, v36, v37
    v_cvt_pk_bf16_f32 v41, v38, v39
    v_lshlrev_b32 v36, 16, v40
    v_and_b32 v37, s34, v40
    v_lshlrev_b32 v38, 16, v41
    v_and_b32 v39, s34, v41
    v_add_f32 v38, s36, v38
    v_cvt_pk_bf16_f32 v38, v38, v38
    v_lshlrev_b32 v38, 16, v38
    v_div_scale_f32 v40, s[6:7], v38, v38, v36
    v_div_scale_f32 v41, vcc, v36, v38, v36
    v_rcp_f32 v42, v40
    s_nop 0
    v_fma_f32 v43, -v40, v42, 1.0
    v_fma_f32 v42, v43, v42, v42
    v_mul_f32 v43, v41, v42
    v_fma_f32 v44, -v40, v43, v41
    v_fma_f32 v43, v44, v42, v43
    v_fma_f32 v40, -v40, v43, v41
    v_div_fmas_f32 v40, v40, v42, v43
    v_div_fixup_f32 v36, v40, v38, v36
    v_div_scale_f32 v40, s[6:7], v38, v38, v37
    v_div_scale_f32 v41, vcc, v37, v38, v37
    v_rcp_f32 v42, v40
    s_nop 0
    v_fma_f32 v43, -v40, v42, 1.0
    v_fma_f32 v42, v43, v42, v42
    v_mul_f32 v43, v41, v42
    v_fma_f32 v44, -v40, v43, v41
    v_fma_f32 v43, v44, v42, v43
    v_fma_f32 v40, -v40, v43, v41
    v_div_fmas_f32 v40, v40, v42, v43
    v_div_fixup_f32 v37, v40, v38, v37
    v_cvt_pk_bf16_f32 v36, v36, v37
    buffer_store_dword v36, v144, s[44:47], s74 offen
L_fin:
L_end:
    s_endpgm
.section .rodata,"a"
.p2align 6
.amdhsa_kernel standalone__linear_kernel_rfa__decode_kernel
  .amdhsa_next_free_vgpr 166
  .amdhsa_next_free_sgpr 80
  .amdhsa_accum_offset 168
  .amdhsa_group_segment_fixed_size 0
  .amdhsa_kernarg_size 56
  .amdhsa_user_sgpr_count 2
  .amdhsa_user_sgpr_kernarg_segment_ptr 1
  .amdhsa_system_sgpr_workgroup_id_x 1
  .amdhsa_float_denorm_mode_32 3
.end_amdhsa_kernel
```
